```python
import torch

def _softmax(x, axis=-1):
    return torch.softmax(x, dim=axis)
def _gelu(x):
    return torch.nn.functional.gelu(x, approximate="tanh")
def _silu(x):
    return torch.nn.functional.silu(x)
def _sigmoid(x):
    return torch.sigmoid(x)
def _layernorm(x, axis=-1, eps=1e-5):
    m = x.mean(dim=axis, keepdim=True)
    v = x.var(dim=axis, keepdim=True, unbiased=False)
    return (x - m) / torch.sqrt(v + eps)
def _scatter_add(tgt, idx, src, axis=0):
    return tgt.clone().index_add_(axis, idx, src)
def _segment_sum(src, seg, n):
    out = torch.zeros((n,) + src.shape[1:], dtype=src.dtype)
    return out.index_add_(0, seg, src)
def _pad(x, pw):
    flat = tuple(v for pair in reversed(pw) for v in pair)
    return torch.nn.functional.pad(x, flat)

kernel_name = 'standalone__rezero__sampling'

def setup_inputs():

    _w = (lambda a: (lambda t: t.to(torch.bfloat16) if t.is_floating_point() else t)(torch.as_tensor(a)))
    B, S, D = 1024, 16, 448
    return {
        "x": _w((lambda *s: torch.randn(*s, dtype=torch.bfloat16) * 0.05)(B, S, D)),
        "fx": _w((lambda *s: torch.randn(*s, dtype=torch.bfloat16) * 0.8)(B, S, D)),
        "alpha": _w((lambda *s: torch.randn(*s, dtype=torch.bfloat16) * 0.8)(1) * 0.1),
    }

def reference(x, fx, alpha):
    return x + alpha * fx
```

```asm
; @launch grid=(256,1,1) block=(256,1,1) lds=0
.amdgcn_target "amdgcn-amd-amdhsa--gfx950"
.text
.globl standalone__rezero__sampling_kernel
.p2align 8
.type standalone__rezero__sampling_kernel,@function
standalone__rezero__sampling_kernel:
    s_load_dwordx8 s[4:11], s[0:1], 0
    s_lshr_b32 s27, s2, 3
    s_cmp_ge_u32 s27, 32
    s_cbranch_scc1 L_end
    s_and_b32 s26, s2, 7
    s_mulk_i32 s26, 448
    s_add_u32 s26, s26, s27
    s_lshl_b32 s24, s26, 12
    v_lshl_add_u32 v20, v0, 4, s24
    s_mov_b32 s19, 0x20000
    s_waitcnt lgkmcnt(0)
    s_load_dword s16, s[8:9], 0
    global_load_dwordx4 v[24:27], v20, s[4:5] nt
    global_load_dwordx4 v[28:31], v20, s[6:7] nt
    v_add_u32 v21, s19, v20
    v_xor_b32 v21, 0x2000, v21
    global_load_dwordx4 v[32:35], v21, s[4:5] nt
    global_load_dwordx4 v[36:39], v21, s[6:7] nt
    v_add_u32 v22, s19, v21
    v_xor_b32 v22, 0x2000, v22
    global_load_dwordx4 v[40:43], v22, s[4:5] nt
    global_load_dwordx4 v[44:47], v22, s[6:7] nt
    v_add_u32 v23, s19, v22
    v_xor_b32 v23, 0x2000, v23
    global_load_dwordx4 v[48:51], v23, s[4:5] nt
    global_load_dwordx4 v[52:55], v23, s[6:7] nt
    s_mov_b32 s18, 0xffff0000
    s_waitcnt lgkmcnt(0)
    s_lshl_b32 s16, s16, 16
    s_waitcnt vmcnt(6)
    v_lshlrev_b32 v4, 16, v28
    v_and_b32 v5, s18, v28
    v_lshlrev_b32 v6, 16, v29
    v_and_b32 v7, s18, v29
    v_lshlrev_b32 v8, 16, v30
    v_and_b32 v9, s18, v30
    v_lshlrev_b32 v10, 16, v31
    v_and_b32 v11, s18, v31
    v_pk_mul_f32 v[4:5], v[4:5], s[16:17] op_sel_hi:[1,0]
    v_pk_mul_f32 v[6:7], v[6:7], s[16:17] op_sel_hi:[1,0]
    v_pk_mul_f32 v[8:9], v[8:9], s[16:17] op_sel_hi:[1,0]
    v_pk_mul_f32 v[10:11], v[10:11], s[16:17] op_sel_hi:[1,0]
    v_lshlrev_b32 v12, 16, v24
    v_and_b32 v13, s18, v24
    v_lshlrev_b32 v14, 16, v25
    v_and_b32 v15, s18, v25
    v_lshlrev_b32 v16, 16, v26
    v_and_b32 v17, s18, v26
    v_lshlrev_b32 v18, 16, v27
    v_and_b32 v19, s18, v27
    v_cvt_pk_bf16_f32 v4, 0, v4
    v_cvt_pk_bf16_f32 v5, 0, v5
    v_cvt_pk_bf16_f32 v6, 0, v6
    v_cvt_pk_bf16_f32 v7, 0, v7
    v_cvt_pk_bf16_f32 v8, 0, v8
    v_cvt_pk_bf16_f32 v9, 0, v9
    v_cvt_pk_bf16_f32 v10, 0, v10
    v_cvt_pk_bf16_f32 v11, 0, v11
    v_pk_add_f32 v[12:13], v[12:13], v[4:5]
    v_pk_add_f32 v[14:15], v[14:15], v[6:7]
    v_pk_add_f32 v[16:17], v[16:17], v[8:9]
    v_pk_add_f32 v[18:19], v[18:19], v[10:11]
    v_cvt_pk_bf16_f32 v24, v12, v13
    v_cvt_pk_bf16_f32 v25, v14, v15
    v_cvt_pk_bf16_f32 v26, v16, v17
    v_cvt_pk_bf16_f32 v27, v18, v19
    global_store_dwordx4 v20, v[24:27], s[10:11]
    v_add_u32 v20, s19, v23
    v_xor_b32 v20, 0x2000, v20
    global_load_dwordx4 v[24:27], v20, s[4:5] nt
    global_load_dwordx4 v[28:31], v20, s[6:7] nt
    s_waitcnt vmcnt(7)
    v_lshlrev_b32 v4, 16, v36
    v_and_b32 v5, s18, v36
    v_lshlrev_b32 v6, 16, v37
    v_and_b32 v7, s18, v37
    v_lshlrev_b32 v8, 16, v38
    v_and_b32 v9, s18, v38
    v_lshlrev_b32 v10, 16, v39
    v_and_b32 v11, s18, v39
    v_pk_mul_f32 v[4:5], v[4:5], s[16:17] op_sel_hi:[1,0]
    v_pk_mul_f32 v[6:7], v[6:7], s[16:17] op_sel_hi:[1,0]
    v_pk_mul_f32 v[8:9], v[8:9], s[16:17] op_sel_hi:[1,0]
    v_pk_mul_f32 v[10:11], v[10:11], s[16:17] op_sel_hi:[1,0]
    v_lshlrev_b32 v12, 16, v32
    v_and_b32 v13, s18, v32
    v_lshlrev_b32 v14, 16, v33
    v_and_b32 v15, s18, v33
    v_lshlrev_b32 v16, 16, v34
    v_and_b32 v17, s18, v34
    v_lshlrev_b32 v18, 16, v35
    v_and_b32 v19, s18, v35
    v_cvt_pk_bf16_f32 v4, 0, v4
    v_cvt_pk_bf16_f32 v5, 0, v5
    v_cvt_pk_bf16_f32 v6, 0, v6
    v_cvt_pk_bf16_f32 v7, 0, v7
    v_cvt_pk_bf16_f32 v8, 0, v8
    v_cvt_pk_bf16_f32 v9, 0, v9
    v_cvt_pk_bf16_f32 v10, 0, v10
    v_cvt_pk_bf16_f32 v11, 0, v11
    v_pk_add_f32 v[12:13], v[12:13], v[4:5]
    v_pk_add_f32 v[14:15], v[14:15], v[6:7]
    v_pk_add_f32 v[16:17], v[16:17], v[8:9]
    v_pk_add_f32 v[18:19], v[18:19], v[10:11]
    v_cvt_pk_bf16_f32 v32, v12, v13
    v_cvt_pk_bf16_f32 v33, v14, v15
    v_cvt_pk_bf16_f32 v34, v16, v17
    v_cvt_pk_bf16_f32 v35, v18, v19
    global_store_dwordx4 v21, v[32:35], s[10:11]
    v_add_u32 v21, s19, v20
    v_xor_b32 v21, 0x2000, v21
    global_load_dwordx4 v[32:35], v21, s[4:5] nt
    global_load_dwordx4 v[36:39], v21, s[6:7] nt
    s_waitcnt vmcnt(8)
    v_lshlrev_b32 v4, 16, v44
    v_and_b32 v5, s18, v44
    v_lshlrev_b32 v6, 16, v45
    v_and_b32 v7, s18, v45
    v_lshlrev_b32 v8, 16, v46
    v_and_b32 v9, s18, v46
    v_lshlrev_b32 v10, 16, v47
    v_and_b32 v11, s18, v47
    v_pk_mul_f32 v[4:5], v[4:5], s[16:17] op_sel_hi:[1,0]
    v_pk_mul_f32 v[6:7], v[6:7], s[16:17] op_sel_hi:[1,0]
    v_pk_mul_f32 v[8:9], v[8:9], s[16:17] op_sel_hi:[1,0]
    v_pk_mul_f32 v[10:11], v[10:11], s[16:17] op_sel_hi:[1,0]
    v_lshlrev_b32 v12, 16, v40
    v_and_b32 v13, s18, v40
    v_lshlrev_b32 v14, 16, v41
    v_and_b32 v15, s18, v41
    v_lshlrev_b32 v16, 16, v42
    v_and_b32 v17, s18, v42
    v_lshlrev_b32 v18, 16, v43
    v_and_b32 v19, s18, v43
    v_cvt_pk_bf16_f32 v4, 0, v4
    v_cvt_pk_bf16_f32 v5, 0, v5
    v_cvt_pk_bf16_f32 v6, 0, v6
    v_cvt_pk_bf16_f32 v7, 0, v7
    v_cvt_pk_bf16_f32 v8, 0, v8
    v_cvt_pk_bf16_f32 v9, 0, v9
    v_cvt_pk_bf16_f32 v10, 0, v10
    v_cvt_pk_bf16_f32 v11, 0, v11
    v_pk_add_f32 v[12:13], v[12:13], v[4:5]
    v_pk_add_f32 v[14:15], v[14:15], v[6:7]
    v_pk_add_f32 v[16:17], v[16:17], v[8:9]
    v_pk_add_f32 v[18:19], v[18:19], v[10:11]
    v_cvt_pk_bf16_f32 v40, v12, v13
    v_cvt_pk_bf16_f32 v41, v14, v15
    v_cvt_pk_bf16_f32 v42, v16, v17
    v_cvt_pk_bf16_f32 v43, v18, v19
    global_store_dwordx4 v22, v[40:43], s[10:11]
    v_add_u32 v22, s19, v21
    v_xor_b32 v22, 0x2000, v22
    global_load_dwordx4 v[40:43], v22, s[4:5] nt
    global_load_dwordx4 v[44:47], v22, s[6:7] nt
    s_waitcnt vmcnt(9)
    v_lshlrev_b32 v4, 16, v52
    v_and_b32 v5, s18, v52
    v_lshlrev_b32 v6, 16, v53
    v_and_b32 v7, s18, v53
    v_lshlrev_b32 v8, 16, v54
    v_and_b32 v9, s18, v54
    v_lshlrev_b32 v10, 16, v55
    v_and_b32 v11, s18, v55
    v_pk_mul_f32 v[4:5], v[4:5], s[16:17] op_sel_hi:[1,0]
    v_pk_mul_f32 v[6:7], v[6:7], s[16:17] op_sel_hi:[1,0]
    v_pk_mul_f32 v[8:9], v[8:9], s[16:17] op_sel_hi:[1,0]
    v_pk_mul_f32 v[10:11], v[10:11], s[16:17] op_sel_hi:[1,0]
    v_lshlrev_b32 v12, 16, v48
    v_and_b32 v13, s18, v48
    v_lshlrev_b32 v14, 16, v49
    v_and_b32 v15, s18, v49
    v_lshlrev_b32 v16, 16, v50
    v_and_b32 v17, s18, v50
    v_lshlrev_b32 v18, 16, v51
    v_and_b32 v19, s18, v51
    v_cvt_pk_bf16_f32 v4, 0, v4
    v_cvt_pk_bf16_f32 v5, 0, v5
    v_cvt_pk_bf16_f32 v6, 0, v6
    v_cvt_pk_bf16_f32 v7, 0, v7
    v_cvt_pk_bf16_f32 v8, 0, v8
    v_cvt_pk_bf16_f32 v9, 0, v9
    v_cvt_pk_bf16_f32 v10, 0, v10
    v_cvt_pk_bf16_f32 v11, 0, v11
    v_pk_add_f32 v[12:13], v[12:13], v[4:5]
    v_pk_add_f32 v[14:15], v[14:15], v[6:7]
    v_pk_add_f32 v[16:17], v[16:17], v[8:9]
    v_pk_add_f32 v[18:19], v[18:19], v[10:11]
    v_cvt_pk_bf16_f32 v48, v12, v13
    v_cvt_pk_bf16_f32 v49, v14, v15
    v_cvt_pk_bf16_f32 v50, v16, v17
    v_cvt_pk_bf16_f32 v51, v18, v19
    global_store_dwordx4 v23, v[48:51], s[10:11]
    v_add_u32 v23, s19, v22
    v_xor_b32 v23, 0x2000, v23
    global_load_dwordx4 v[48:51], v23, s[4:5] nt
    global_load_dwordx4 v[52:55], v23, s[6:7] nt
    s_waitcnt vmcnt(9)
    v_lshlrev_b32 v4, 16, v28
    v_and_b32 v5, s18, v28
    v_lshlrev_b32 v6, 16, v29
    v_and_b32 v7, s18, v29
    v_lshlrev_b32 v8, 16, v30
    v_and_b32 v9, s18, v30
    v_lshlrev_b32 v10, 16, v31
    v_and_b32 v11, s18, v31
    v_pk_mul_f32 v[4:5], v[4:5], s[16:17] op_sel_hi:[1,0]
    v_pk_mul_f32 v[6:7], v[6:7], s[16:17] op_sel_hi:[1,0]
    v_pk_mul_f32 v[8:9], v[8:9], s[16:17] op_sel_hi:[1,0]
    v_pk_mul_f32 v[10:11], v[10:11], s[16:17] op_sel_hi:[1,0]
    v_lshlrev_b32 v12, 16, v24
    v_and_b32 v13, s18, v24
    v_lshlrev_b32 v14, 16, v25
    v_and_b32 v15, s18, v25
    v_lshlrev_b32 v16, 16, v26
    v_and_b32 v17, s18, v26
    v_lshlrev_b32 v18, 16, v27
    v_and_b32 v19, s18, v27
    v_cvt_pk_bf16_f32 v4, 0, v4
    v_cvt_pk_bf16_f32 v5, 0, v5
    v_cvt_pk_bf16_f32 v6, 0, v6
    v_cvt_pk_bf16_f32 v7, 0, v7
    v_cvt_pk_bf16_f32 v8, 0, v8
    v_cvt_pk_bf16_f32 v9, 0, v9
    v_cvt_pk_bf16_f32 v10, 0, v10
    v_cvt_pk_bf16_f32 v11, 0, v11
    v_pk_add_f32 v[12:13], v[12:13], v[4:5]
    v_pk_add_f32 v[14:15], v[14:15], v[6:7]
    v_pk_add_f32 v[16:17], v[16:17], v[8:9]
    v_pk_add_f32 v[18:19], v[18:19], v[10:11]
    v_cvt_pk_bf16_f32 v24, v12, v13
    v_cvt_pk_bf16_f32 v25, v14, v15
    v_cvt_pk_bf16_f32 v26, v16, v17
    v_cvt_pk_bf16_f32 v27, v18, v19
    global_store_dwordx4 v20, v[24:27], s[10:11]
    v_add_u32 v20, s19, v23
    v_xor_b32 v20, 0x2000, v20
    global_load_dwordx4 v[24:27], v20, s[4:5] nt
    global_load_dwordx4 v[28:31], v20, s[6:7] nt
    s_waitcnt vmcnt(9)
    v_lshlrev_b32 v4, 16, v36
    v_and_b32 v5, s18, v36
    v_lshlrev_b32 v6, 16, v37
    v_and_b32 v7, s18, v37
    v_lshlrev_b32 v8, 16, v38
    v_and_b32 v9, s18, v38
    v_lshlrev_b32 v10, 16, v39
    v_and_b32 v11, s18, v39
    v_pk_mul_f32 v[4:5], v[4:5], s[16:17] op_sel_hi:[1,0]
    v_pk_mul_f32 v[6:7], v[6:7], s[16:17] op_sel_hi:[1,0]
    v_pk_mul_f32 v[8:9], v[8:9], s[16:17] op_sel_hi:[1,0]
    v_pk_mul_f32 v[10:11], v[10:11], s[16:17] op_sel_hi:[1,0]
    v_lshlrev_b32 v12, 16, v32
    v_and_b32 v13, s18, v32
    v_lshlrev_b32 v14, 16, v33
    v_and_b32 v15, s18, v33
    v_lshlrev_b32 v16, 16, v34
    v_and_b32 v17, s18, v34
    v_lshlrev_b32 v18, 16, v35
    v_and_b32 v19, s18, v35
    v_cvt_pk_bf16_f32 v4, 0, v4
    v_cvt_pk_bf16_f32 v5, 0, v5
    v_cvt_pk_bf16_f32 v6, 0, v6
    v_cvt_pk_bf16_f32 v7, 0, v7
    v_cvt_pk_bf16_f32 v8, 0, v8
    v_cvt_pk_bf16_f32 v9, 0, v9
    v_cvt_pk_bf16_f32 v10, 0, v10
    v_cvt_pk_bf16_f32 v11, 0, v11
    v_pk_add_f32 v[12:13], v[12:13], v[4:5]
    v_pk_add_f32 v[14:15], v[14:15], v[6:7]
    v_pk_add_f32 v[16:17], v[16:17], v[8:9]
    v_pk_add_f32 v[18:19], v[18:19], v[10:11]
    v_cvt_pk_bf16_f32 v32, v12, v13
    v_cvt_pk_bf16_f32 v33, v14, v15
    v_cvt_pk_bf16_f32 v34, v16, v17
    v_cvt_pk_bf16_f32 v35, v18, v19
    global_store_dwordx4 v21, v[32:35], s[10:11]
    v_add_u32 v21, s19, v20
    v_xor_b32 v21, 0x2000, v21
    global_load_dwordx4 v[32:35], v21, s[4:5] nt
    global_load_dwordx4 v[36:39], v21, s[6:7] nt
    s_waitcnt vmcnt(9)
    v_lshlrev_b32 v4, 16, v44
    v_and_b32 v5, s18, v44
    v_lshlrev_b32 v6, 16, v45
    v_and_b32 v7, s18, v45
    v_lshlrev_b32 v8, 16, v46
    v_and_b32 v9, s18, v46
    v_lshlrev_b32 v10, 16, v47
    v_and_b32 v11, s18, v47
    v_pk_mul_f32 v[4:5], v[4:5], s[16:17] op_sel_hi:[1,0]
    v_pk_mul_f32 v[6:7], v[6:7], s[16:17] op_sel_hi:[1,0]
    v_pk_mul_f32 v[8:9], v[8:9], s[16:17] op_sel_hi:[1,0]
    v_pk_mul_f32 v[10:11], v[10:11], s[16:17] op_sel_hi:[1,0]
    v_lshlrev_b32 v12, 16, v40
    v_and_b32 v13, s18, v40
    v_lshlrev_b32 v14, 16, v41
    v_and_b32 v15, s18, v41
    v_lshlrev_b32 v16, 16, v42
    v_and_b32 v17, s18, v42
    v_lshlrev_b32 v18, 16, v43
    v_and_b32 v19, s18, v43
    v_cvt_pk_bf16_f32 v4, 0, v4
    v_cvt_pk_bf16_f32 v5, 0, v5
    v_cvt_pk_bf16_f32 v6, 0, v6
    v_cvt_pk_bf16_f32 v7, 0, v7
    v_cvt_pk_bf16_f32 v8, 0, v8
    v_cvt_pk_bf16_f32 v9, 0, v9
    v_cvt_pk_bf16_f32 v10, 0, v10
    v_cvt_pk_bf16_f32 v11, 0, v11
    v_pk_add_f32 v[12:13], v[12:13], v[4:5]
    v_pk_add_f32 v[14:15], v[14:15], v[6:7]
    v_pk_add_f32 v[16:17], v[16:17], v[8:9]
    v_pk_add_f32 v[18:19], v[18:19], v[10:11]
    v_cvt_pk_bf16_f32 v40, v12, v13
    v_cvt_pk_bf16_f32 v41, v14, v15
    v_cvt_pk_bf16_f32 v42, v16, v17
    v_cvt_pk_bf16_f32 v43, v18, v19
    global_store_dwordx4 v22, v[40:43], s[10:11]
    v_add_u32 v22, s19, v21
    v_xor_b32 v22, 0x2000, v22
    global_load_dwordx4 v[40:43], v22, s[4:5] nt
    global_load_dwordx4 v[44:47], v22, s[6:7] nt
    s_waitcnt vmcnt(9)
    v_lshlrev_b32 v4, 16, v52
    v_and_b32 v5, s18, v52
    v_lshlrev_b32 v6, 16, v53
    v_and_b32 v7, s18, v53
    v_lshlrev_b32 v8, 16, v54
    v_and_b32 v9, s18, v54
    v_lshlrev_b32 v10, 16, v55
    v_and_b32 v11, s18, v55
    v_pk_mul_f32 v[4:5], v[4:5], s[16:17] op_sel_hi:[1,0]
    v_pk_mul_f32 v[6:7], v[6:7], s[16:17] op_sel_hi:[1,0]
    v_pk_mul_f32 v[8:9], v[8:9], s[16:17] op_sel_hi:[1,0]
    v_pk_mul_f32 v[10:11], v[10:11], s[16:17] op_sel_hi:[1,0]
    v_lshlrev_b32 v12, 16, v48
    v_and_b32 v13, s18, v48
    v_lshlrev_b32 v14, 16, v49
    v_and_b32 v15, s18, v49
    v_lshlrev_b32 v16, 16, v50
    v_and_b32 v17, s18, v50
    v_lshlrev_b32 v18, 16, v51
    v_and_b32 v19, s18, v51
    v_cvt_pk_bf16_f32 v4, 0, v4
    v_cvt_pk_bf16_f32 v5, 0, v5
    v_cvt_pk_bf16_f32 v6, 0, v6
    v_cvt_pk_bf16_f32 v7, 0, v7
    v_cvt_pk_bf16_f32 v8, 0, v8
    v_cvt_pk_bf16_f32 v9, 0, v9
    v_cvt_pk_bf16_f32 v10, 0, v10
    v_cvt_pk_bf16_f32 v11, 0, v11
    v_pk_add_f32 v[12:13], v[12:13], v[4:5]
    v_pk_add_f32 v[14:15], v[14:15], v[6:7]
    v_pk_add_f32 v[16:17], v[16:17], v[8:9]
    v_pk_add_f32 v[18:19], v[18:19], v[10:11]
    v_cvt_pk_bf16_f32 v48, v12, v13
    v_cvt_pk_bf16_f32 v49, v14, v15
    v_cvt_pk_bf16_f32 v50, v16, v17
    v_cvt_pk_bf16_f32 v51, v18, v19
    global_store_dwordx4 v23, v[48:51], s[10:11]
    v_add_u32 v23, s19, v22
    v_xor_b32 v23, 0x2000, v23
    global_load_dwordx4 v[48:51], v23, s[4:5] nt
    global_load_dwordx4 v[52:55], v23, s[6:7] nt
    s_waitcnt vmcnt(9)
    v_lshlrev_b32 v4, 16, v28
    v_and_b32 v5, s18, v28
    v_lshlrev_b32 v6, 16, v29
    v_and_b32 v7, s18, v29
    v_lshlrev_b32 v8, 16, v30
    v_and_b32 v9, s18, v30
    v_lshlrev_b32 v10, 16, v31
    v_and_b32 v11, s18, v31
    v_pk_mul_f32 v[4:5], v[4:5], s[16:17] op_sel_hi:[1,0]
    v_pk_mul_f32 v[6:7], v[6:7], s[16:17] op_sel_hi:[1,0]
    v_pk_mul_f32 v[8:9], v[8:9], s[16:17] op_sel_hi:[1,0]
    v_pk_mul_f32 v[10:11], v[10:11], s[16:17] op_sel_hi:[1,0]
    v_lshlrev_b32 v12, 16, v24
    v_and_b32 v13, s18, v24
    v_lshlrev_b32 v14, 16, v25
    v_and_b32 v15, s18, v25
    v_lshlrev_b32 v16, 16, v26
    v_and_b32 v17, s18, v26
    v_lshlrev_b32 v18, 16, v27
    v_and_b32 v19, s18, v27
    v_cvt_pk_bf16_f32 v4, 0, v4
    v_cvt_pk_bf16_f32 v5, 0, v5
    v_cvt_pk_bf16_f32 v6, 0, v6
    v_cvt_pk_bf16_f32 v7, 0, v7
    v_cvt_pk_bf16_f32 v8, 0, v8
    v_cvt_pk_bf16_f32 v9, 0, v9
    v_cvt_pk_bf16_f32 v10, 0, v10
    v_cvt_pk_bf16_f32 v11, 0, v11
    v_pk_add_f32 v[12:13], v[12:13], v[4:5]
    v_pk_add_f32 v[14:15], v[14:15], v[6:7]
    v_pk_add_f32 v[16:17], v[16:17], v[8:9]
    v_pk_add_f32 v[18:19], v[18:19], v[10:11]
    v_cvt_pk_bf16_f32 v24, v12, v13
    v_cvt_pk_bf16_f32 v25, v14, v15
    v_cvt_pk_bf16_f32 v26, v16, v17
    v_cvt_pk_bf16_f32 v27, v18, v19
    global_store_dwordx4 v20, v[24:27], s[10:11]
    v_add_u32 v20, s19, v23
    v_xor_b32 v20, 0x2000, v20
    global_load_dwordx4 v[24:27], v20, s[4:5] nt
    global_load_dwordx4 v[28:31], v20, s[6:7] nt
    s_waitcnt vmcnt(9)
    v_lshlrev_b32 v4, 16, v36
    v_and_b32 v5, s18, v36
    v_lshlrev_b32 v6, 16, v37
    v_and_b32 v7, s18, v37
    v_lshlrev_b32 v8, 16, v38
    v_and_b32 v9, s18, v38
    v_lshlrev_b32 v10, 16, v39
    v_and_b32 v11, s18, v39
    v_pk_mul_f32 v[4:5], v[4:5], s[16:17] op_sel_hi:[1,0]
    v_pk_mul_f32 v[6:7], v[6:7], s[16:17] op_sel_hi:[1,0]
    v_pk_mul_f32 v[8:9], v[8:9], s[16:17] op_sel_hi:[1,0]
    v_pk_mul_f32 v[10:11], v[10:11], s[16:17] op_sel_hi:[1,0]
    v_lshlrev_b32 v12, 16, v32
    v_and_b32 v13, s18, v32
    v_lshlrev_b32 v14, 16, v33
    v_and_b32 v15, s18, v33
    v_lshlrev_b32 v16, 16, v34
    v_and_b32 v17, s18, v34
    v_lshlrev_b32 v18, 16, v35
    v_and_b32 v19, s18, v35
    v_cvt_pk_bf16_f32 v4, 0, v4
    v_cvt_pk_bf16_f32 v5, 0, v5
    v_cvt_pk_bf16_f32 v6, 0, v6
    v_cvt_pk_bf16_f32 v7, 0, v7
    v_cvt_pk_bf16_f32 v8, 0, v8
    v_cvt_pk_bf16_f32 v9, 0, v9
    v_cvt_pk_bf16_f32 v10, 0, v10
    v_cvt_pk_bf16_f32 v11, 0, v11
    v_pk_add_f32 v[12:13], v[12:13], v[4:5]
    v_pk_add_f32 v[14:15], v[14:15], v[6:7]
    v_pk_add_f32 v[16:17], v[16:17], v[8:9]
    v_pk_add_f32 v[18:19], v[18:19], v[10:11]
    v_cvt_pk_bf16_f32 v32, v12, v13
    v_cvt_pk_bf16_f32 v33, v14, v15
    v_cvt_pk_bf16_f32 v34, v16, v17
    v_cvt_pk_bf16_f32 v35, v18, v19
    global_store_dwordx4 v21, v[32:35], s[10:11]
    v_add_u32 v21, s19, v20
    v_xor_b32 v21, 0x2000, v21
    global_load_dwordx4 v[32:35], v21, s[4:5] nt
    global_load_dwordx4 v[36:39], v21, s[6:7] nt
    s_waitcnt vmcnt(9)
    v_lshlrev_b32 v4, 16, v44
    v_and_b32 v5, s18, v44
    v_lshlrev_b32 v6, 16, v45
    v_and_b32 v7, s18, v45
    v_lshlrev_b32 v8, 16, v46
    v_and_b32 v9, s18, v46
    v_lshlrev_b32 v10, 16, v47
    v_and_b32 v11, s18, v47
    v_pk_mul_f32 v[4:5], v[4:5], s[16:17] op_sel_hi:[1,0]
    v_pk_mul_f32 v[6:7], v[6:7], s[16:17] op_sel_hi:[1,0]
    v_pk_mul_f32 v[8:9], v[8:9], s[16:17] op_sel_hi:[1,0]
    v_pk_mul_f32 v[10:11], v[10:11], s[16:17] op_sel_hi:[1,0]
    v_lshlrev_b32 v12, 16, v40
    v_and_b32 v13, s18, v40
    v_lshlrev_b32 v14, 16, v41
    v_and_b32 v15, s18, v41
    v_lshlrev_b32 v16, 16, v42
    v_and_b32 v17, s18, v42
    v_lshlrev_b32 v18, 16, v43
    v_and_b32 v19, s18, v43
    v_cvt_pk_bf16_f32 v4, 0, v4
    v_cvt_pk_bf16_f32 v5, 0, v5
    v_cvt_pk_bf16_f32 v6, 0, v6
    v_cvt_pk_bf16_f32 v7, 0, v7
    v_cvt_pk_bf16_f32 v8, 0, v8
    v_cvt_pk_bf16_f32 v9, 0, v9
    v_cvt_pk_bf16_f32 v10, 0, v10
    v_cvt_pk_bf16_f32 v11, 0, v11
    v_pk_add_f32 v[12:13], v[12:13], v[4:5]
    v_pk_add_f32 v[14:15], v[14:15], v[6:7]
    v_pk_add_f32 v[16:17], v[16:17], v[8:9]
    v_pk_add_f32 v[18:19], v[18:19], v[10:11]
    v_cvt_pk_bf16_f32 v40, v12, v13
    v_cvt_pk_bf16_f32 v41, v14, v15
    v_cvt_pk_bf16_f32 v42, v16, v17
    v_cvt_pk_bf16_f32 v43, v18, v19
    global_store_dwordx4 v22, v[40:43], s[10:11]
    s_waitcnt vmcnt(7)
    v_lshlrev_b32 v4, 16, v52
    v_and_b32 v5, s18, v52
    v_lshlrev_b32 v6, 16, v53
    v_and_b32 v7, s18, v53
    v_lshlrev_b32 v8, 16, v54
    v_and_b32 v9, s18, v54
    v_lshlrev_b32 v10, 16, v55
    v_and_b32 v11, s18, v55
    v_pk_mul_f32 v[4:5], v[4:5], s[16:17] op_sel_hi:[1,0]
    v_pk_mul_f32 v[6:7], v[6:7], s[16:17] op_sel_hi:[1,0]
    v_pk_mul_f32 v[8:9], v[8:9], s[16:17] op_sel_hi:[1,0]
    v_pk_mul_f32 v[10:11], v[10:11], s[16:17] op_sel_hi:[1,0]
    v_lshlrev_b32 v12, 16, v48
    v_and_b32 v13, s18, v48
    v_lshlrev_b32 v14, 16, v49
    v_and_b32 v15, s18, v49
    v_lshlrev_b32 v16, 16, v50
    v_and_b32 v17, s18, v50
    v_lshlrev_b32 v18, 16, v51
    v_and_b32 v19, s18, v51
    v_cvt_pk_bf16_f32 v4, 0, v4
    v_cvt_pk_bf16_f32 v5, 0, v5
    v_cvt_pk_bf16_f32 v6, 0, v6
    v_cvt_pk_bf16_f32 v7, 0, v7
    v_cvt_pk_bf16_f32 v8, 0, v8
    v_cvt_pk_bf16_f32 v9, 0, v9
    v_cvt_pk_bf16_f32 v10, 0, v10
    v_cvt_pk_bf16_f32 v11, 0, v11
    v_pk_add_f32 v[12:13], v[12:13], v[4:5]
    v_pk_add_f32 v[14:15], v[14:15], v[6:7]
    v_pk_add_f32 v[16:17], v[16:17], v[8:9]
    v_pk_add_f32 v[18:19], v[18:19], v[10:11]
    v_cvt_pk_bf16_f32 v48, v12, v13
    v_cvt_pk_bf16_f32 v49, v14, v15
    v_cvt_pk_bf16_f32 v50, v16, v17
    v_cvt_pk_bf16_f32 v51, v18, v19
    global_store_dwordx4 v23, v[48:51], s[10:11]
    s_waitcnt vmcnt(5)
    v_lshlrev_b32 v4, 16, v28
    v_and_b32 v5, s18, v28
    v_lshlrev_b32 v6, 16, v29
    v_and_b32 v7, s18, v29
    v_lshlrev_b32 v8, 16, v30
    v_and_b32 v9, s18, v30
    v_lshlrev_b32 v10, 16, v31
    v_and_b32 v11, s18, v31
    v_pk_mul_f32 v[4:5], v[4:5], s[16:17] op_sel_hi:[1,0]
    v_pk_mul_f32 v[6:7], v[6:7], s[16:17] op_sel_hi:[1,0]
    v_pk_mul_f32 v[8:9], v[8:9], s[16:17] op_sel_hi:[1,0]
    v_pk_mul_f32 v[10:11], v[10:11], s[16:17] op_sel_hi:[1,0]
    v_lshlrev_b32 v12, 16, v24
    v_and_b32 v13, s18, v24
    v_lshlrev_b32 v14, 16, v25
    v_and_b32 v15, s18, v25
    v_lshlrev_b32 v16, 16, v26
    v_and_b32 v17, s18, v26
    v_lshlrev_b32 v18, 16, v27
    v_and_b32 v19, s18, v27
    v_cvt_pk_bf16_f32 v4, 0, v4
    v_cvt_pk_bf16_f32 v5, 0, v5
    v_cvt_pk_bf16_f32 v6, 0, v6
    v_cvt_pk_bf16_f32 v7, 0, v7
    v_cvt_pk_bf16_f32 v8, 0, v8
    v_cvt_pk_bf16_f32 v9, 0, v9
    v_cvt_pk_bf16_f32 v10, 0, v10
    v_cvt_pk_bf16_f32 v11, 0, v11
    v_pk_add_f32 v[12:13], v[12:13], v[4:5]
    v_pk_add_f32 v[14:15], v[14:15], v[6:7]
    v_pk_add_f32 v[16:17], v[16:17], v[8:9]
    v_pk_add_f32 v[18:19], v[18:19], v[10:11]
    v_cvt_pk_bf16_f32 v24, v12, v13
    v_cvt_pk_bf16_f32 v25, v14, v15
    v_cvt_pk_bf16_f32 v26, v16, v17
    v_cvt_pk_bf16_f32 v27, v18, v19
    global_store_dwordx4 v20, v[24:27], s[10:11]
    s_waitcnt vmcnt(3)
    v_lshlrev_b32 v4, 16, v36
    v_and_b32 v5, s18, v36
    v_lshlrev_b32 v6, 16, v37
    v_and_b32 v7, s18, v37
    v_lshlrev_b32 v8, 16, v38
    v_and_b32 v9, s18, v38
    v_lshlrev_b32 v10, 16, v39
    v_and_b32 v11, s18, v39
    v_pk_mul_f32 v[4:5], v[4:5], s[16:17] op_sel_hi:[1,0]
    v_pk_mul_f32 v[6:7], v[6:7], s[16:17] op_sel_hi:[1,0]
    v_pk_mul_f32 v[8:9], v[8:9], s[16:17] op_sel_hi:[1,0]
    v_pk_mul_f32 v[10:11], v[10:11], s[16:17] op_sel_hi:[1,0]
    v_lshlrev_b32 v12, 16, v32
    v_and_b32 v13, s18, v32
    v_lshlrev_b32 v14, 16, v33
    v_and_b32 v15, s18, v33
    v_lshlrev_b32 v16, 16, v34
    v_and_b32 v17, s18, v34
    v_lshlrev_b32 v18, 16, v35
    v_and_b32 v19, s18, v35
    v_cvt_pk_bf16_f32 v4, 0, v4
    v_cvt_pk_bf16_f32 v5, 0, v5
    v_cvt_pk_bf16_f32 v6, 0, v6
    v_cvt_pk_bf16_f32 v7, 0, v7
    v_cvt_pk_bf16_f32 v8, 0, v8
    v_cvt_pk_bf16_f32 v9, 0, v9
    v_cvt_pk_bf16_f32 v10, 0, v10
    v_cvt_pk_bf16_f32 v11, 0, v11
    v_pk_add_f32 v[12:13], v[12:13], v[4:5]
    v_pk_add_f32 v[14:15], v[14:15], v[6:7]
    v_pk_add_f32 v[16:17], v[16:17], v[8:9]
    v_pk_add_f32 v[18:19], v[18:19], v[10:11]
    v_cvt_pk_bf16_f32 v32, v12, v13
    v_cvt_pk_bf16_f32 v33, v14, v15
    v_cvt_pk_bf16_f32 v34, v16, v17
    v_cvt_pk_bf16_f32 v35, v18, v19
    global_store_dwordx4 v21, v[32:35], s[10:11]
L_end:
    s_endpgm
.section .rodata,"a"
.p2align 6
.amdhsa_kernel standalone__rezero__sampling_kernel
  .amdhsa_next_free_vgpr 56
  .amdhsa_next_free_sgpr 28
  .amdhsa_accum_offset 56
  .amdhsa_group_segment_fixed_size 0
  .amdhsa_kernarg_size 48
  .amdhsa_user_sgpr_count 2
  .amdhsa_user_sgpr_kernarg_segment_ptr 1
  .amdhsa_system_sgpr_workgroup_id_x 1
  .amdhsa_float_denorm_mode_32 3
.end_amdhsa_kernel
```
